```python
import torch

def _softmax(x, axis=-1):
    return torch.softmax(x, dim=axis)
def _gelu(x):
    return torch.nn.functional.gelu(x, approximate="tanh")
def _silu(x):
    return torch.nn.functional.silu(x)
def _sigmoid(x):
    return torch.sigmoid(x)
def _layernorm(x, axis=-1, eps=1e-5):
    m = x.mean(dim=axis, keepdim=True)
    v = x.var(dim=axis, keepdim=True, unbiased=False)
    return (x - m) / torch.sqrt(v + eps)
def _scatter_add(tgt, idx, src, axis=0):
    return tgt.clone().index_add_(axis, idx, src)
def _segment_sum(src, seg, n):
    out = torch.zeros((n,) + src.shape[1:], dtype=src.dtype)
    return out.index_add_(0, seg, src)
def _pad(x, pw):
    flat = tuple(v for pair in reversed(pw) for v in pair)
    return torch.nn.functional.pad(x, flat)

kernel_name = 'gated_mix__compressed_kv_cla__dense_activation_silu__decode'

def setup_inputs():

    _w = (lambda a: (lambda t: t.to(torch.bfloat16) if t.is_floating_point() else t)(torch.as_tensor(a)))
    def _A_setup():
        B, H, Sq, Sk, D, M = 1, 32, 1, 8192, 128, 512
        Dc = 4 * D
        return {
            "x": _w((lambda *s: torch.randn(*s, dtype=torch.bfloat16) * 0.05)(B, Sq, M)),
            "c_kv": _w((lambda *s: torch.randn(*s, dtype=torch.bfloat16) * 0.8)(B, Sk, Dc)),
            "w_q": _w((lambda *s: torch.randn(*s, dtype=torch.bfloat16) * 6.4)(M, H, D) * (M ** -0.5)),
            "w_uk": _w((lambda *s: torch.randn(*s, dtype=torch.bfloat16) * 6.4)(Dc, H, D) * (Dc ** -0.5)),
            "w_uv": _w((lambda *s: torch.randn(*s, dtype=torch.bfloat16) * 0.8)(Dc, H, D) * (Dc ** -0.5)),
            "w_o": _w((lambda *s: torch.randn(*s, dtype=torch.bfloat16) * 0.8)(H, D, M) * ((H * D) ** -0.5)),
        }
    _A_in = _A_setup()

    def _B_setup():
        B, S, D, F = 1, 1, 512, 1376
        return {
            "x": _w((lambda *s: torch.randn(*s, dtype=torch.bfloat16) * 0.05)(B, S, D)),
            "w1": _w((lambda *s: torch.randn(*s, dtype=torch.bfloat16) * 12.8)(D, F) * (D ** -0.5)),
            "w2": _w((lambda *s: torch.randn(*s, dtype=torch.bfloat16) * 0.1)(F, D) * (F ** -0.5)),
        }
    _B_in = _B_setup()

    return {
        "A_x": _A_in["x"],
        "A_c_kv": _A_in["c_kv"],
        "A_w_q": _A_in["w_q"],
        "A_w_uk": _A_in["w_uk"],
        "A_w_uv": _A_in["w_uv"],
        "A_w_o": _A_in["w_o"],
        "B_x": _B_in["x"],
        "B_w1": _B_in["w1"],
        "B_w2": _B_in["w2"],
        "gate_w": _w((lambda *s: torch.randn(*s, dtype=torch.bfloat16) * 0.05)(512) * 16.0),
    }

def reference(A_x, A_c_kv, A_w_q, A_w_uk, A_w_uv, A_w_o, B_x, B_w1, B_w2, gate_w):
    def _A_ref(x, c_kv, w_q, w_uk, w_uv, w_o):
        B, Sq, M = x.shape[0], x.shape[1], x.shape[2]
        Sk = c_kv.shape[1]
        H, D = w_q.shape[1], w_q.shape[2]
        q = torch.einsum("bqm,mhd->bhqd", x, w_q)
        k = torch.einsum("bkc,chd->bhkd", c_kv, w_uk)
        v = torch.einsum("bkc,chd->bhkd", c_kv, w_uv)
        scores = torch.einsum("bhqd,bhkd->bhqk", q, k) * (D ** -0.5)
        off = Sk - Sq
        qi = torch.arange(Sq)[:, None]
        kj = torch.arange(Sk)[None, :]
        cmask = kj <= (qi + off)
        scores = torch.where(cmask[None, None], scores, -1e9)
        p = _softmax(scores, axis=-1)
        ctx = torch.einsum("bhqk,bhkd->bhqd", p, v)
        return torch.einsum("bhqd,hdm->bqm", ctx, w_o)

    def _B_ref(x, w1, w2):
        h = torch.einsum("bsd,df->bsf", x, w1)
        h = _silu(h)
        out = torch.einsum("bsf,fd->bsd", h, w2)
        return out

    x = A_x
    g = _sigmoid((x * gate_w).sum(-1, keepdims=True))
    a = _A_ref(x, A_c_kv, A_w_q, A_w_uk, A_w_uv, A_w_o)
    b = _B_ref(x, B_w1, B_w2)
    return g * a + (1 - g) * b
```

```asm
; @launch grid=(256,1,1) block=(256,1,1) lds=139648
.amdgcn_target "amdgcn-amd-amdhsa--gfx950"
.text
.globl gated_mix__compressed_kv_cla__dense_activation_silu__decode_kernel
.p2align 8
.type gated_mix__compressed_kv_cla__dense_activation_silu__decode_kernel,@function
gated_mix__compressed_kv_cla__dense_activation_silu__decode_kernel:
  s_load_dwordx16 s[4:19], s[0:1], 0
  s_load_dwordx8 s[20:27], s[0:1], 64
  s_load_dwordx2 s[28:29], s[0:1], 96
  s_cmp_ge_u32 s2, 256
  s_cbranch_scc1 Lend
  s_getpc_b64 s[64:65]
Lpc:
  v_lshlrev_b32 v12, 7, v0
  v_min_u32 v12, Lcode_end-Lpc-4, v12
  global_load_dword v11, v12, s[64:65]
  v_lshrrev_b32 v14, 6, v0
  v_and_b32 v1, 63, v0
  v_readfirstlane_b32 s30, v14
  s_and_b32 s34, s2, 7
  s_lshr_b32 s35, s2, 3
  s_lshr_b32 s36, s35, 3
  s_lshl2_add_u32 s32, s34, s36
  s_and_b32 s33, s35, 7
  v_lshrrev_b32 v2, 4, v1
  v_and_b32 v3, 15, v0
  v_lshlrev_b32 v4, 2, v2
  v_xor_b32 v4, v4, v3
  v_lshlrev_b32 v4, 4, v4
  s_lshr_b32 s54, s30, 1
  s_and_b32 s55, s30, 1
  s_lshl3_add_u32 s54, s54, s55
  s_lshl4_add_u32 s54, s33, s54
  s_lshl_b32 s54, s54, 15
  s_lshl_b32 s55, s32, 8
  s_add_u32 s54, s54, s55
  v_lshl_add_u32 v26, v2, 13, v4
  v_add_u32 v26, s54, v26
  s_mul_i32 s41, s30, 8448
  s_add_u32 m0, s41, 105536
  s_lshl_b32 s55, s33, 7
  v_lshl_add_u32 v7, v2, 4, s55
  v_add_u32 v27, 64496, v26
  v_add_u32 v28, 128992, v26
  v_add_u32 v29, 193488, v26
  s_add_u32 s58, s36, s33
  s_waitcnt lgkmcnt(0)
  s_load_dword s31, s[28:29], 0
  global_load_lds_dwordx4 v26, s[8:9] offset:0
  global_load_lds_dwordx4 v27, s[8:9] offset:1040
  global_load_lds_dwordx4 v28, s[8:9] offset:2080
  global_load_lds_dwordx4 v29, s[8:9] offset:3120
  global_load_dwordx4 v[36:39], v7, s[4:5]
  global_load_dwordx4 v[40:43], v7, s[4:5] offset:64
  s_bitcmp1_b32 s58, 0
  s_cbranch_scc1 Lapath
  s_add_u32 m0, s41, 67584
  s_barrier
  global_load_lds_dwordx4 v26, s[10:11] offset:0
  global_load_lds_dwordx4 v27, s[10:11] offset:1040
  global_load_lds_dwordx4 v28, s[10:11] offset:2080
  global_load_lds_dwordx4 v29, s[10:11] offset:3120
  s_add_u32 m0, m0, 4160
  v_xor_b32 v26, 0x80000, v26
  global_load_lds_dwordx4 v26, s[10:11] offset:0
  v_xor_b32 v27, 0x80000, v27
  global_load_lds_dwordx4 v27, s[10:11] offset:1040
  v_xor_b32 v28, 0x80000, v28
  global_load_lds_dwordx4 v28, s[10:11] offset:2080
  v_xor_b32 v29, 0x80000, v29
  global_load_lds_dwordx4 v29, s[10:11] offset:3120
  v_bfe_u32 v5, v0, 2, 2
  v_and_b32 v6, 3, v0
  v_mul_u32_u24 v20, 1040, v2
  v_lshl_add_u32 v20, v5, 8, v20
  v_and_b32 v21, 2, v0
  v_lshl_add_u32 v20, v21, 4, v20
  v_and_b32 v21, 1, v0
  v_lshl_add_u32 v25, v21, 3, v20
  v_xor_b32 v22, s30, v5
  v_lshl_add_u32 v8, v22, 6, v25
  v_add_u32 v9, 101376, v8
  s_lshl_b32 s54, s32, 13
  s_add_u32 s54, s54, 266240
  s_lshl2_add_u32 s58, s33, s30
  s_lshl_b32 s55, s58, 7
  s_add_u32 s55, s54, s55
  v_lshl_add_u32 v20, v2, 1, v3
  v_lshl_add_u32 v10, v20, 4, s55
  s_mov_b32 s50, 0x00020002
  s_mov_b32 s51, s50
  s_mov_b32 s52, 0x00030003
  s_mov_b32 s53, s52
  s_lshr_b32 s59, s33, 1
  s_mov_b32 s66, 0
  s_mov_b32 s38, 0
  v_lshl_add_u32 v80, v0, 4, s54
  s_waitcnt lgkmcnt(0)
  s_add_u32 s31, s31, 0x9e3779b1
  v_mov_b32 v33, s31
  v_mov_b32 v53, s31
  v_mov_b32 v55, s31
  s_waitcnt vmcnt(8)
  s_barrier
  ds_read_b64_tr_b16 v[64:65], v9 offset:4160
  ds_read_b64_tr_b16 v[66:67], v9 offset:12608
  ds_read_b64_tr_b16 v[68:69], v9 offset:21056
  ds_read_b64_tr_b16 v[70:71], v9 offset:29504
  ds_read_b64_tr_b16 v[72:73], v9 offset:4176
  ds_read_b64_tr_b16 v[74:75], v9 offset:12624
  ds_read_b64_tr_b16 v[76:77], v9 offset:21072
  ds_read_b64_tr_b16 v[78:79], v9 offset:29520
  s_waitcnt lgkmcnt(6)
  v_mfma_f32_16x16x32_bf16 v[56:59], v[64:67], v[36:39], 0
  s_waitcnt lgkmcnt(4)
  v_mfma_f32_16x16x32_bf16 v[56:59], v[68:71], v[40:43], v[56:59]
  s_waitcnt lgkmcnt(2)
  v_mfma_f32_16x16x32_bf16 v[60:63], v[72:75], v[36:39], 0
  s_waitcnt lgkmcnt(0)
  v_mfma_f32_16x16x32_bf16 v[60:63], v[76:79], v[40:43], v[60:63]
  s_nop 0
  v_cvt_pk_bf16_f32 v12, v56, v57
  v_cvt_pk_bf16_f32 v13, v58, v59
  s_nop 4
  v_cvt_pk_bf16_f32 v14, v60, v61
  v_cvt_pk_bf16_f32 v15, v62, v63
  s_mov_b64 exec, s[52:53]
  v_cndmask_b32 v52, v12, v14, s[50:51]
  v_cndmask_b32 v54, v13, v15, s[50:51]
  global_store_dwordx4 v10, v[52:55], s[28:29]
  s_mov_b64 exec, -1
  v_lshrrev_b32 v20, 5, v0
  v_and_b32 v22, 3, v20
  v_lshlrev_b32 v23, 8, v20
  v_lshl_add_u32 v23, v22, 4, v23
  v_and_b32 v22, 4, v20
  v_lshl_add_u32 v23, v22, 5, v23
  v_and_b32 v22, 28, v0
  v_lshl_add_u32 v23, v22, 3, v23
  v_lshl_add_u32 v23, v21, 4, v23
  v_and_b32 v22, 2, v0
  v_lshl_add_u32 v23, v22, 2, v23
  v_add_u32 v81, 135168, v23
  v_and_b32 v86, 7, v0
  v_and_b32 v20, 4, v0
  v_lshlrev_b32 v20, 5, v20
  v_lshl_add_u32 v20, v6, 4, v20
  v_lshl_add_u32 v20, v2, 6, v20
  v_lshl_add_u32 v20, v86, 8, v20
  v_add_u32 v82, 135168, v20
  v_mul_u32_u24 v20, 1040, v5
  v_lshl_add_u32 v20, v6, 8, v20
  v_xor_b32 v22, v2, v6
  v_lshl_add_u32 v20, v22, 6, v20
  s_add_u32 s55, s41, 67584
  v_add_u32 v83, s55, v20
  s_lshr_b32 s54, s32, 4
  s_lshl2_add_u32 s54, s54, s59
  s_bfe_u32 s55, s58, 0x20001
  s_lshl2_add_u32 s64, s54, s30
  s_lshl_b32 s54, s54, 5
  s_add_u32 s54, s54, s55
  s_and_b32 s55, s32, 15
  s_lshl4_add_u32 s64, s64, s55
  s_lshl4_add_u32 s54, s54, s55
  s_and_b32 s55, s30, 1
  s_lshl1_add_u32 s54, s54, s55
  s_lshl3_add_u32 s54, s54, 65536
  v_and_b32 v24, 1, v2
  v_mov_b32 v85, 0x3e0293ee
  v_or_b32 v20, v24, v3
  v_lshlrev_b32 v20, 9, v20
  v_xor_b32 v84, s54, v20
  s_lshl2_add_u32 s54, s32, s30
  s_lshl_b32 s54, s54, 7
  s_add_u32 s54, s54, s59
  s_lshl_b32 s54, s54, 8
  v_lshl_add_u32 v20, v2, 10, v4
  v_add_u32 v88, s54, v20
  s_lshr_b32 s54, s30, 1
  s_lshl3_add_u32 s54, s59, s54
  s_and_b32 s55, s30, 1
  s_lshl2_add_u32 s54, s54, s55
  s_lshl_b32 s54, s54, 7
  s_add_u32 s54, s54, s32
  s_lshl_b32 s54, s54, 8
  v_lshrrev_b32 v23, 5, v1
  v_lshl_add_u32 v20, v23, 18, v4
  v_lshl_add_u32 v20, v24, 16, v20
  v_add_u32 v87, s54, v20
  v_xor_b32 v7, 128, v7
  s_lshl3_add_u32 s39, s36, s34
  s_lshl_b32 s40, s39, 7
  s_min_u32 s40, s40, 2624
  s_cmp_lt_u32 s39, 22
  s_cselect_b64 s[60:61], -1, 1
  v_lshlrev_b32 v22, 2, v24
  v_xor_b32 v22, v22, v86
  v_lshrrev_b32 v20, 3, v1
  v_mul_u32_u24 v20, 2752, v20
  v_lshl_add_u32 v20, v22, 4, v20
  s_lshl_b32 s54, s33, 1
  s_xor_b32 s54, s54, s30
  s_mul_i32 s54, s54, 88064
  s_add_u32 s54, s54, s40
  v_add_u32 v100, s54, v20
  s_waitcnt vmcnt(0)
  global_load_dwordx4 v[112:115], v80, s[28:29] sc1
  ds_read_b128 a[0:3], v83 offset:0
  ds_read_b128 a[4:7], v83 offset:16
  ds_read_b128 a[8:11], v83 offset:32
  ds_read_b128 a[12:15], v83 offset:48
  ds_read_b128 a[16:19], v83 offset:4160
  ds_read_b128 a[20:23], v83 offset:4176
  ds_read_b128 a[24:27], v83 offset:4192
  ds_read_b128 a[28:31], v83 offset:4208
  s_waitcnt vmcnt(0)
Lq_chk:
  ds_write2_b32 v81, v112, v114 offset0:0 offset1:1
  v_bitop3_b32 v12, v113, v115, s31 bitop3:0x7e
  v_cmp_ne_u32 vcc, 0, v12
  s_cbranch_vccnz Lq_retry
Lq_ok:
  s_mov_b64 exec, s[52:53]
  global_store_dwordx4 v10, v[52:55], s[28:29] offset:-4096 sc1
  s_mov_b64 exec, -1
  s_mov_b32 s38, 0
  s_waitcnt lgkmcnt(0)
  s_barrier
  ds_read_b128 v[64:67], v82 offset:0
  ds_read_b128 v[68:71], v82 offset:16
  ds_read_b128 v[72:75], v82 offset:32
  ds_read_b128 v[76:79], v82 offset:48
  s_waitcnt lgkmcnt(3)
  v_mfma_f32_16x16x32_bf16 v[56:59], v[64:67], a[0:3], 0
  v_mfma_f32_16x16x32_bf16 v[60:63], v[64:67], a[16:19], 0
  s_waitcnt lgkmcnt(2)
  v_mfma_f32_16x16x32_bf16 v[56:59], v[68:71], a[4:7], v[56:59]
  v_mfma_f32_16x16x32_bf16 v[60:63], v[68:71], a[20:23], v[60:63]
  s_waitcnt lgkmcnt(1)
  v_mfma_f32_16x16x32_bf16 v[56:59], v[72:75], a[8:11], v[56:59]
  v_mfma_f32_16x16x32_bf16 v[60:63], v[72:75], a[24:27], v[60:63]
  s_waitcnt lgkmcnt(0)
  v_mfma_f32_16x16x32_bf16 v[56:59], v[76:79], a[12:15], v[56:59]
  v_mfma_f32_16x16x32_bf16 v[60:63], v[76:79], a[28:31], v[60:63]
  s_nop 4
  v_pk_add_f32 v[56:57], v[56:57], v[58:59]
  v_add_f32 v12, v56, v57
  s_nop 0
  v_pk_add_f32 v[60:61], v[60:61], v[62:63]
  v_add_f32 v14, v60, v61
  s_nop 1
  v_permlane16_swap_b32 v12, v14
  v_add_f32 v12, v12, v14
  v_mul_f32 v13, v12, v85
  s_nop 0
  v_mul_f32_dpp v14, v12, v85 quad_perm:[1,1,3,3] row_mask:0xf bank_mask:0xf
  s_mov_b64 exec, 0x55555555
  v_cvt_pk_bf16_f32 v32, v13, v14
  global_store_dwordx2 v84, v[32:33], s[28:29] sc1
  s_mov_b64 exec, -1
  s_barrier
  s_mov_b64 exec, s[60:61]
  global_load_dwordx4 v[44:47], v7, s[4:5]
  global_load_dwordx4 v[48:51], v7, s[4:5] offset:64
  s_add_u32 m0, s41, 67584
  s_nop 0
  global_load_lds_dwordx4 v100, s[18:19] offset:0
  v_add_u32 v100, 0x51e0, v100
  global_load_lds_dwordx4 v100, s[18:19] offset:1056
  s_waitcnt vmcnt(5)
  v_add_u32 v100, 0x51e0, v100
  global_load_lds_dwordx4 v100, s[18:19] offset:2112
  s_waitcnt vmcnt(5)
  v_add_u32 v100, 0x51e0, v100
  global_load_lds_dwordx4 v100, s[18:19] offset:3168
  s_mov_b64 exec, -1
  s_waitcnt vmcnt(5)
  s_add_u32 m0, s41, 0
  s_nop 0
  global_load_lds_dwordx4 v87, s[12:13] offset:0
  s_waitcnt vmcnt(5)
  v_add_u32 v87, 0x1bf0, v87
  global_load_lds_dwordx4 v87, s[12:13] offset:1040
  s_lshl2_add_u32 s37, s32, s59
  s_lshl2_add_u32 s58, s59, s30
  v_mul_u32_u24 v20, 1056, v2
  v_lshl_add_u32 v20, v5, 7, v20
  v_and_b32 v22, 2, v5
  v_xor_b32 v22, s30, v22
  v_lshl_add_u32 v20, v22, 5, v20
  v_lshl_add_u32 v20, v6, 3, v20
  v_add_u32 v101, 67584, v20
  s_lshl_b32 s54, s39, 5
  s_add_u32 s54, s54, s58
  s_lshl_b32 s54, s54, 7
  s_add_u32 s54, s54, 133120
  v_lshl_add_u32 v102, v3, 3, s54
  s_lshl_b32 s54, s58, 9
  s_add_u32 s54, s54, s32
  s_lshl_b32 s54, s54, 5
  s_add_u32 s54, s54, 786432
  v_and_b32 v20, 14, v0
  v_lshl_add_u32 v20, v20, 10, s54
  v_lshl_add_u32 v97, v21, 4, v20
  s_lshl2_add_u32 s58, s37, s30
  s_lshl_b32 s54, s58, 8
  s_add_u32 s54, s54, 524288
  v_lshl_add_u32 v20, v6, 2, v2
  v_lshl_add_u32 v20, v20, 1, v5
  v_lshl_add_u32 v89, v20, 3, s54
  s_lshl_b32 s54, s58, 12
  s_add_u32 s54, s54, 1048576
  v_lshl_add_u32 v90, v1, 4, s54
  s_mul_i32 s54, s30, 320
  s_add_u32 s54, s54, 137728
  v_lshl_add_u32 v20, v3, 1, v2
  v_lshl_add_u32 v91, v20, 3, s54
  v_mul_u32_u24 v20, 320, v6
  v_lshl_add_u32 v20, v2, 4, v20
  v_add_u32 v92, 137728, v20
  v_mov_b32 v94, 139008
  v_lshl_add_u32 v93, s30, 2, v94
  s_lshl_b32 s54, s32, 11
  s_add_u32 s54, s54, 656384
  v_lshl_add_u32 v20, v2, 2, v6
  v_lshl_add_u32 v96, v20, 4, s54
  s_lshl4_add_u32 s55, s30, s59
  s_lshl4_add_u32 s54, s55, s54
  v_and_b32 v20, 8, v0
  v_lshl_add_u32 v20, v20, 4, s54
  v_lshl_add_u32 v20, v24, 6, v20
  v_lshl_add_u32 v95, v86, 1, v20
  v_lshlrev_b32 v22, 4, v21
  s_mov_b32 s54, 0xffff
  v_lshlrev_b32 v22, v22, s54
  v_lshrrev_b32 v20, 1, v86
  s_mov_b32 s56, 0x000f000f
  s_mov_b32 s57, s56
  s_mov_b32 s42, 0x00ff00ff
  s_mov_b32 s43, s42
  v_mov_b64 v[30:31], 0
  v_cmp_eq_u32 vcc, 0, v20
  s_nop 1
  v_cndmask_b32 v103, 0, v22, vcc
  v_cmp_eq_u32 vcc, 1, v20
  s_nop 1
  v_cndmask_b32 v104, 0, v22, vcc
  v_cmp_eq_u32 vcc, 2, v20
  s_nop 1
  v_cndmask_b32 v105, 0, v22, vcc
  v_cmp_eq_u32 vcc, 3, v20
  s_nop 1
  v_cndmask_b32 v106, 0, v22, vcc
  v_mov_b64 v[132:133], 0
  v_mov_b64 v[134:135], 0
  v_mov_b64 v[136:137], 0
  v_mov_b64 v[138:139], 0
  v_mov_b64 v[140:141], 0
  v_mov_b64 v[142:143], 0
  v_mov_b64 v[144:145], 0
  v_mov_b64 v[146:147], 0
  v_mov_b64 v[148:149], 0
  v_mov_b64 v[150:151], 0
  v_mov_b64 v[152:153], 0
  v_mov_b64 v[154:155], 0
  v_mov_b64 v[156:157], 0
  v_mov_b64 v[158:159], 0
  v_mov_b64 v[160:161], 0
  v_mov_b64 v[162:163], 0
  s_waitcnt vmcnt(5)
  v_add_u32 v87, 0x1bf0, v87
  global_load_lds_dwordx4 v87, s[12:13] offset:2080
  s_waitcnt vmcnt(5)
  v_add_u32 v87, 0x1bf0, v87
  global_load_lds_dwordx4 v87, s[12:13] offset:3120
  s_waitcnt vmcnt(5)
  s_add_u32 m0, s41, 4160
  v_add_u32 v87, 0x7ac30, v87
  global_load_lds_dwordx4 v87, s[12:13] offset:0
  s_waitcnt vmcnt(5)
  v_add_u32 v87, 0x1bf0, v87
  global_load_lds_dwordx4 v87, s[12:13] offset:1040
  s_waitcnt vmcnt(5)
  v_add_u32 v87, 0x1bf0, v87
  global_load_lds_dwordx4 v87, s[12:13] offset:2080
  s_waitcnt vmcnt(5)
  v_add_u32 v87, 0x1bf0, v87
  global_load_lds_dwordx4 v87, s[12:13] offset:3120
  s_waitcnt vmcnt(5)
  s_add_u32 m0, s41, 33792
  s_nop 0
  global_load_lds_dwordx4 v88, s[14:15] offset:0
  s_waitcnt vmcnt(5)
  v_add_u32 v88, 0x1bf0, v88
  global_load_lds_dwordx4 v88, s[14:15] offset:1040
  s_barrier
  ds_read_b64_tr_b16 a[96:97], v101 offset:0
  ds_read_b64_tr_b16 a[98:99], v101 offset:512
  ds_read_b64_tr_b16 a[100:101], v101 offset:8448
  ds_read_b64_tr_b16 a[102:103], v101 offset:8960
  ds_read_b64_tr_b16 a[104:105], v101 offset:16896
  ds_read_b64_tr_b16 a[106:107], v101 offset:17408
  ds_read_b64_tr_b16 a[108:109], v101 offset:25344
  ds_read_b64_tr_b16 a[110:111], v101 offset:25856
  s_waitcnt lgkmcnt(6)
  v_mfma_f32_16x16x32_bf16 v[56:59], v[36:39], a[96:99], 0
  s_waitcnt lgkmcnt(4)
  v_mfma_f32_16x16x32_bf16 v[56:59], v[40:43], a[100:103], v[56:59]
  s_waitcnt lgkmcnt(2)
  v_mfma_f32_16x16x32_bf16 v[56:59], v[44:47], a[104:107], v[56:59]
  s_waitcnt lgkmcnt(0)
  v_mfma_f32_16x16x32_bf16 v[56:59], v[48:51], a[108:111], v[56:59]
  s_mov_b64 exec, 0xffff
  s_nop 6
  v_mov_b32 v32, v56
  global_store_dwordx2 v102, v[32:33], s[28:29]
  s_mov_b64 exec, -1
  s_waitcnt vmcnt(5)
  v_add_u32 v88, 0x1bf0, v88
  global_load_lds_dwordx4 v88, s[14:15] offset:2080
  s_waitcnt vmcnt(5)
  v_add_u32 v88, 0x1bf0, v88
  global_load_lds_dwordx4 v88, s[14:15] offset:3120
  s_waitcnt vmcnt(5)
  s_add_u32 m0, s41, 37952
  v_add_u32 v88, 0xffffbc30, v88
  global_load_lds_dwordx4 v88, s[14:15] offset:0
  s_waitcnt vmcnt(5)
  v_add_u32 v88, 0x1bf0, v88
  global_load_lds_dwordx4 v88, s[14:15] offset:1040
  s_waitcnt vmcnt(5)
  v_add_u32 v88, 0x1bf0, v88
  global_load_lds_dwordx4 v88, s[14:15] offset:2080
  s_waitcnt vmcnt(5)
  v_add_u32 v88, 0x1bf0, v88
  global_load_lds_dwordx4 v88, s[14:15] offset:3120
  global_load_ushort v11, v95, s[28:29] sc1
  s_mov_b64 exec, s[42:43]
  s_waitcnt vmcnt(3)
  global_atomic_or_x2 v[112:113], v89, v[30:31], s[28:29] sc0 sc1
  s_waitcnt vmcnt(2)
  s_mov_b64 exec, -1
  s_barrier
  ds_read_b64_tr_b16 a[32:33], v8 offset:0
  ds_read_b64_tr_b16 a[34:35], v8 offset:4160
  ds_read_b64_tr_b16 a[36:37], v8 offset:8448
  ds_read_b64_tr_b16 a[38:39], v8 offset:12608
  ds_read_b64_tr_b16 a[40:41], v8 offset:16896
  ds_read_b64_tr_b16 a[42:43], v8 offset:21056
  ds_read_b64_tr_b16 a[44:45], v8 offset:25344
  ds_read_b64_tr_b16 a[46:47], v8 offset:29504
  ds_read_b64_tr_b16 a[48:49], v8 offset:16
  ds_read_b64_tr_b16 a[50:51], v8 offset:4176
  ds_read_b64_tr_b16 a[52:53], v8 offset:8464
  ds_read_b64_tr_b16 a[54:55], v8 offset:12624
  ds_read_b64_tr_b16 a[56:57], v8 offset:16912
  ds_read_b64_tr_b16 a[58:59], v8 offset:21072
  ds_read_b64_tr_b16 a[60:61], v8 offset:25360
  ds_read_b64_tr_b16 a[62:63], v8 offset:29520
  ds_read_b64_tr_b16 a[64:65], v8 offset:33792
  ds_read_b64_tr_b16 a[66:67], v8 offset:37952
  ds_read_b64_tr_b16 a[68:69], v8 offset:42240
  ds_read_b64_tr_b16 a[70:71], v8 offset:46400
  ds_read_b64_tr_b16 a[72:73], v8 offset:50688
  ds_read_b64_tr_b16 a[74:75], v8 offset:54848
  ds_read_b64_tr_b16 a[76:77], v8 offset:59136
  ds_read_b64_tr_b16 a[78:79], v8 offset:63296
  ds_read_b64_tr_b16 a[80:81], v8 offset:33808
  ds_read_b64_tr_b16 a[82:83], v8 offset:37968
  ds_read_b64_tr_b16 a[84:85], v8 offset:42256
  ds_read_b64_tr_b16 a[86:87], v8 offset:46416
  ds_read_b64_tr_b16 a[88:89], v8 offset:50704
  ds_read_b64_tr_b16 a[90:91], v8 offset:54864
  ds_read_b64_tr_b16 a[92:93], v8 offset:59152
  ds_read_b64_tr_b16 a[94:95], v8 offset:63312
  s_mov_b64 exec, s[42:43]
Lml_loop:
  s_waitcnt vmcnt(0)
  v_cmp_ne_u32 vcc, s31, v113
  v_mov_b32 v108, v112
  s_cbranch_vccz Lml_ok
  global_atomic_or_x2 v[112:113], v89, v[30:31], s[28:29] sc0 sc1
  s_add_u32 s66, s66, 1
  s_cmp_le_u32 s66, 20000
  s_cbranch_scc1 Lml_loop
Lml_ok:
  s_mov_b64 exec, -1
  global_load_dwordx4 v[116:119], v90, s[28:29] offset:0 sc1
  global_load_dwordx4 v[120:123], v90, s[28:29] offset:1024 sc1
  global_load_dwordx4 v[124:127], v90, s[28:29] offset:2048 sc1
  global_load_dwordx4 v[128:131], v90, s[28:29] offset:3072 sc1
  v_max_f32_dpp v16, v108, v108 quad_perm:[1,0,3,2] row_mask:0xf bank_mask:0xf
  s_nop 1
  v_max_f32_dpp v16, v16, v16 quad_perm:[2,3,0,1] row_mask:0xf bank_mask:0xf
  v_mov_b32 v13, v16
  s_nop 1
  v_permlane16_swap_b32 v13, v16
  v_max_f32 v16, v16, v13
  v_mov_b32 v13, v16
  s_nop 1
  v_permlane32_swap_b32 v13, v16
  v_max_f32 v16, v16, v13
  v_sub_f32 v17, v108, v16
  v_exp_f32 v17, v17
  s_nop 0
  v_cvt_pk_bf16_f32 v17, v17, v17
  v_lshlrev_b32 v18, 16, v17
  s_nop 0
  v_and_b32_dpp v64, v17, v103 row_newbcast:0 row_mask:0xf bank_mask:0xf
  v_and_b32_dpp v65, v17, v104 row_newbcast:0 row_mask:0xf bank_mask:0xf
  v_and_b32_dpp v66, v17, v105 row_newbcast:0 row_mask:0xf bank_mask:0xf
  v_and_b32_dpp v67, v17, v106 row_newbcast:0 row_mask:0xf bank_mask:0xf
  v_and_b32_dpp v68, v17, v103 row_newbcast:1 row_mask:0xf bank_mask:0xf
  v_and_b32_dpp v69, v17, v104 row_newbcast:1 row_mask:0xf bank_mask:0xf
  v_and_b32_dpp v70, v17, v105 row_newbcast:1 row_mask:0xf bank_mask:0xf
  v_and_b32_dpp v71, v17, v106 row_newbcast:1 row_mask:0xf bank_mask:0xf
  v_and_b32_dpp v72, v17, v103 row_newbcast:2 row_mask:0xf bank_mask:0xf
  v_and_b32_dpp v73, v17, v104 row_newbcast:2 row_mask:0xf bank_mask:0xf
  v_and_b32_dpp v74, v17, v105 row_newbcast:2 row_mask:0xf bank_mask:0xf
  v_and_b32_dpp v75, v17, v106 row_newbcast:2 row_mask:0xf bank_mask:0xf
  v_and_b32_dpp v76, v17, v103 row_newbcast:3 row_mask:0xf bank_mask:0xf
  v_and_b32_dpp v77, v17, v104 row_newbcast:3 row_mask:0xf bank_mask:0xf
  v_and_b32_dpp v78, v17, v105 row_newbcast:3 row_mask:0xf bank_mask:0xf
  v_and_b32_dpp v79, v17, v106 row_newbcast:3 row_mask:0xf bank_mask:0xf
  v_mul_f32_dpp v18, v108, v18 row_shl:4 row_mask:0xf bank_mask:0xf
  s_nop 1
  v_add_f32_dpp v18, v18, v18 quad_perm:[1,0,3,2] row_mask:0xf bank_mask:0xf
  s_nop 1
  v_add_f32_dpp v18, v18, v18 quad_perm:[2,3,0,1] row_mask:0xf bank_mask:0xf
  v_mov_b32 v13, v18
  s_nop 1
  v_permlane16_swap_b32 v13, v18
  v_add_f32 v18, v18, v13
  v_mov_b32 v13, v18
  s_nop 1
  v_permlane32_swap_b32 v13, v18
  v_add_f32 v18, v18, v13
  s_mov_b64 exec, 1
  ds_write2_b32 v93, v16, v18 offset0:0 offset1:4
  s_mov_b64 exec, -1
  s_waitcnt vmcnt(3)
Lo_chk:
  v_mfma_f32_16x16x32_bf16 v[56:59], v[64:67], v[116:119], 0
  v_max3_u32 v12, v116, v117, v118
  s_waitcnt vmcnt(2)
  v_mfma_f32_16x16x32_bf16 v[56:59], v[68:71], v[120:123], v[56:59]
  v_max3_u32 v13, v120, v121, v122
  v_max3_u32 v13, v13, v119, v123
  s_waitcnt vmcnt(1)
  v_mfma_f32_16x16x32_bf16 v[56:59], v[72:75], v[124:127], v[56:59]
  v_max3_u32 v14, v124, v125, v126
  s_waitcnt vmcnt(0)
  v_mfma_f32_16x16x32_bf16 v[56:59], v[76:79], v[128:131], v[56:59]
  v_max3_u32 v15, v128, v129, v130
  v_max3_u32 v15, v15, v127, v131
  v_max3_u32 v12, v12, v13, v14
  v_max_u32 v12, v12, v15
  v_cmp_eq_u32 vcc, -1, v12
  s_cbranch_vccnz Lo_retry
Lo_ok:
  s_mov_b32 exec_hi, 0
  s_nop 0
  v_cvt_pk_bf16_f32 v60, v56, v57
  v_cvt_pk_bf16_f32 v61, v58, v59
  ds_write_b64 v91, v[60:61]
  s_mov_b64 exec, -1
  s_waitcnt lgkmcnt(0)
  s_barrier
  ds_read_b128 v[64:67], v92
  ds_read_b128 v[164:167], v94 offset:0
  ds_read_b128 v[168:171], v94 offset:16
  ds_read_b128 v[68:71], v92 offset:64
  ds_read_b128 v[72:75], v92 offset:128
  ds_read_b128 v[76:79], v92 offset:192
  s_waitcnt lgkmcnt(5)
  v_mfma_f32_16x16x32_bf16 v[56:59], v[64:67], a[32:35], 0
  s_waitcnt lgkmcnt(3)
  v_max3_f32 v12, v164, v165, v166
  v_max_f32 v108, v12, v167
  v_mfma_f32_16x16x32_bf16 v[60:63], v[64:67], a[48:51], 0
  v_pk_add_f32 v[164:165], v[164:165], v[108:109] op_sel_hi:[1,0] neg_lo:[0,1] neg_hi:[0,1]
  v_pk_add_f32 v[166:167], v[166:167], v[108:109] op_sel_hi:[1,0] neg_lo:[0,1] neg_hi:[0,1]
  s_waitcnt lgkmcnt(2)
  v_mfma_f32_16x16x32_bf16 v[56:59], v[68:71], a[36:39], v[56:59]
  v_exp_f32 v164, v164
  v_mfma_f32_16x16x32_bf16 v[60:63], v[68:71], a[52:55], v[60:63]
  v_exp_f32 v165, v165
  s_waitcnt lgkmcnt(1)
  v_mfma_f32_16x16x32_bf16 v[56:59], v[72:75], a[40:43], v[56:59]
  v_exp_f32 v166, v166
  s_waitcnt lgkmcnt(0)
  v_mfma_f32_16x16x32_bf16 v[56:59], v[76:79], a[44:47], v[56:59]
  v_exp_f32 v167, v167
  v_mfma_f32_16x16x32_bf16 v[60:63], v[72:75], a[56:59], v[60:63]
  v_pk_mul_f32 v[168:169], v[164:165], v[168:169]
  v_pk_fma_f32 v[168:169], v[166:167], v[170:171], v[168:169]
  v_mfma_f32_16x16x32_bf16 v[60:63], v[76:79], a[60:63], v[60:63]
  v_add_f32 v18, v168, v169
  v_rcp_f32 v18, v18
  v_pk_mul_f32 v[56:57], v[56:57], v[164:165]
  v_pk_fma_f32 v[56:57], v[58:59], v[166:167], v[56:57]
  s_mov_b32 exec_lo, 0xffff0000
  s_nop 2
  v_pk_mul_f32 v[56:57], v[60:61], v[164:165]
  v_pk_fma_f32 v[56:57], v[62:63], v[166:167], v[56:57]
  s_mov_b32 exec_lo, -1
  v_add_f32 v12, v56, v57
  v_mul_f32 v13, v12, v18
  s_nop 0
  v_mul_f32_dpp v14, v12, v18 quad_perm:[1,1,3,3] row_mask:0xf bank_mask:0xf
  s_mov_b64 exec, 0x55555555
  v_cvt_pk_bf16_f32 v98, v13, v14
  global_store_dword v95, v98, s[28:29]
  s_mov_b64 exec, s[56:57]
  s_barrier
  global_load_dwordx4 v[132:135], v96, s[28:29] offset:0 sc1
  global_load_dwordx4 v[136:139], v96, s[28:29] offset:256 sc1
  global_load_dwordx4 v[140:143], v96, s[28:29] offset:512 sc1
  global_load_dwordx4 v[144:147], v96, s[28:29] offset:768 sc1
  global_load_dwordx4 v[148:151], v96, s[28:29] offset:0 sc1
  global_load_dwordx4 v[152:155], v96, s[28:29] offset:256 sc1
  global_load_dwordx4 v[156:159], v96, s[28:29] offset:512 sc1
  global_load_dwordx4 v[160:163], v96, s[28:29] offset:768 sc1
Ly_loop:
  s_waitcnt vmcnt(7)
  v_mfma_f32_16x16x32_bf16 v[56:59], v[132:135], a[64:67], 0
  v_mfma_f32_16x16x32_bf16 v[60:63], v[132:135], a[80:83], 0
  v_max3_u32 v12, v132, v133, v134
  s_waitcnt vmcnt(6)
  v_mfma_f32_16x16x32_bf16 v[56:59], v[136:139], a[68:71], v[56:59]
  v_mfma_f32_16x16x32_bf16 v[60:63], v[136:139], a[84:87], v[60:63]
  v_max3_u32 v13, v136, v137, v138
  v_max3_u32 v13, v13, v135, v139
  s_waitcnt vmcnt(5)
  v_mfma_f32_16x16x32_bf16 v[56:59], v[140:143], a[72:75], v[56:59]
  v_mfma_f32_16x16x32_bf16 v[60:63], v[140:143], a[88:91], v[60:63]
  v_max3_u32 v14, v140, v141, v142
  s_waitcnt vmcnt(4)
  v_mfma_f32_16x16x32_bf16 v[56:59], v[144:147], a[76:79], v[56:59]
  v_mfma_f32_16x16x32_bf16 v[60:63], v[144:147], a[92:95], v[60:63]
  v_max3_u32 v15, v144, v145, v146
  v_max3_u32 v15, v15, v143, v147
  v_max3_u32 v12, v12, v13, v14
  v_max_u32 v12, v12, v15
  v_cmp_eq_u32 vcc, -1, v12
  s_cbranch_vccz Ly_ok
  global_load_dwordx4 v[132:135], v96, s[28:29] offset:0 sc1
  global_load_dwordx4 v[136:139], v96, s[28:29] offset:256 sc1
  global_load_dwordx4 v[140:143], v96, s[28:29] offset:512 sc1
  global_load_dwordx4 v[144:147], v96, s[28:29] offset:768 sc1
  s_waitcnt vmcnt(7)
  v_mfma_f32_16x16x32_bf16 v[56:59], v[148:151], a[64:67], 0
  v_mfma_f32_16x16x32_bf16 v[60:63], v[148:151], a[80:83], 0
  v_max3_u32 v12, v148, v149, v150
  s_waitcnt vmcnt(6)
  v_mfma_f32_16x16x32_bf16 v[56:59], v[152:155], a[68:71], v[56:59]
  v_mfma_f32_16x16x32_bf16 v[60:63], v[152:155], a[84:87], v[60:63]
  v_max3_u32 v13, v152, v153, v154
  v_max3_u32 v13, v13, v151, v155
  s_waitcnt vmcnt(5)
  v_mfma_f32_16x16x32_bf16 v[56:59], v[156:159], a[72:75], v[56:59]
  v_mfma_f32_16x16x32_bf16 v[60:63], v[156:159], a[88:91], v[60:63]
  v_max3_u32 v14, v156, v157, v158
  s_waitcnt vmcnt(4)
  v_mfma_f32_16x16x32_bf16 v[56:59], v[160:163], a[76:79], v[56:59]
  v_mfma_f32_16x16x32_bf16 v[60:63], v[160:163], a[92:95], v[60:63]
  v_max3_u32 v15, v160, v161, v162
  v_max3_u32 v15, v15, v159, v163
  v_max3_u32 v12, v12, v13, v14
  v_max_u32 v12, v12, v15
  v_cmp_eq_u32 vcc, -1, v12
  s_cbranch_vccz Ly_ok
  global_load_dwordx4 v[148:151], v96, s[28:29] offset:0 sc1
  global_load_dwordx4 v[152:155], v96, s[28:29] offset:256 sc1
  global_load_dwordx4 v[156:159], v96, s[28:29] offset:512 sc1
  global_load_dwordx4 v[160:163], v96, s[28:29] offset:768 sc1
  s_add_u32 s38, s38, 1
  s_cmp_lt_u32 s38, 11
  s_cbranch_scc1 Ly_loop
  s_waitcnt vmcnt(0)
  s_mov_b64 exec, -1
Ly_chk:
  v_mfma_f32_16x16x32_bf16 v[56:59], v[132:135], a[64:67], 0
  v_mfma_f32_16x16x32_bf16 v[60:63], v[132:135], a[80:83], 0
  v_max3_u32 v12, v132, v133, v134
  v_mfma_f32_16x16x32_bf16 v[56:59], v[136:139], a[68:71], v[56:59]
  v_mfma_f32_16x16x32_bf16 v[60:63], v[136:139], a[84:87], v[60:63]
  v_max3_u32 v13, v136, v137, v138
  v_max3_u32 v13, v13, v135, v139
  v_mfma_f32_16x16x32_bf16 v[56:59], v[140:143], a[72:75], v[56:59]
  v_mfma_f32_16x16x32_bf16 v[60:63], v[140:143], a[88:91], v[60:63]
  v_max3_u32 v14, v140, v141, v142
  v_mfma_f32_16x16x32_bf16 v[56:59], v[144:147], a[76:79], v[56:59]
  v_mfma_f32_16x16x32_bf16 v[60:63], v[144:147], a[92:95], v[60:63]
  v_max3_u32 v15, v144, v145, v146
  v_max3_u32 v15, v15, v143, v147
  v_max3_u32 v12, v12, v13, v14
  v_max_u32 v12, v12, v15
  v_cmp_eq_u32 vcc, -1, v12
  s_cbranch_vccnz Ly_retry
Ly_ok:
  s_mov_b64 exec, 0xffff
  v_pk_add_f32 v[56:57], v[56:57], v[58:59]
  v_add_f32 v52, v56, v57
  v_pk_add_f32 v[60:61], v[60:61], v[62:63]
  v_add_f32 v54, v60, v61
  global_store_dwordx4 v97, v[52:55], s[28:29] sc1
  global_store_dwordx2 v102, v[32:33], s[28:29] offset:-2048 sc1
  s_mov_b64 exec, 0x55555555
  global_store_dword v95, v98, s[28:29] offset:-1024 sc1
Lend:
  s_endpgm
Lqa_retry:
  s_nop 7
  s_add_u32 s66, s66, 1
  s_cmp_gt_u32 s66, 20000
  s_cbranch_scc1 Lqa_ok
  s_waitcnt lgkmcnt(0)
  global_load_dwordx4 v[112:115], v98, s[28:29] offset:-4096 sc1
  global_load_dwordx4 v[116:119], v98, s[28:29] offset:-3072 sc1
  global_load_dwordx4 v[120:123], v98, s[28:29] offset:-2048 sc1
  global_load_dwordx4 v[124:127], v98, s[28:29] offset:-1024 sc1
  global_load_dwordx4 v[128:131], v98, s[28:29] offset:0 sc1
  global_load_dwordx4 v[132:135], v98, s[28:29] offset:1024 sc1
  global_load_dwordx4 v[136:139], v98, s[28:29] offset:2048 sc1
  global_load_dwordx4 v[140:143], v98, s[28:29] offset:3072 sc1
  s_waitcnt vmcnt(0)
  s_nop 1
  s_branch Lqa_chk
Lf_retry:
  s_nop 7
  s_add_u32 s66, s66, 1
  s_cmp_gt_u32 s66, 20000
  s_cbranch_scc1 Lf_ok
  s_waitcnt lgkmcnt(0)
  s_add_u32 s38, s38, 1
  s_cmp_ge_u32 s38, 12
  s_cbranch_scc1 Lf_far
  global_load_dwordx4 v[112:115], v202, s[28:29] offset:0 sc1
  global_load_dwordx4 v[116:119], v202, s[28:29] offset:1024 sc1
  s_waitcnt vmcnt(0)
  s_nop 1
  s_branch Lf_chk
Lf_far:
  s_cmp_lg_u32 s38, 12
  s_cbranch_scc1 Lf_far2
Lf_far2:
  global_load_dwordx4 v[112:115], v202, s[28:29] offset:-2048 sc1
  global_load_dwordx4 v[116:119], v202, s[28:29] offset:-1024 sc1
  s_waitcnt vmcnt(0)
  s_nop 1
  s_branch Lf_chk
Lrf_retry:
  s_nop 7
  s_add_u32 s66, s66, 1
  s_cmp_gt_u32 s66, 20000
  s_cbranch_scc1 Lrf_ok
  s_waitcnt lgkmcnt(0)
  global_atomic_or_x2 v[112:113], v104, v[30:31], s[28:29] offset:0 sc0 sc1
  global_atomic_or_x2 v[114:115], v104, v[30:31], s[28:29] offset:512 sc0 sc1
  global_atomic_or_x2 v[116:117], v104, v[30:31], s[28:29] offset:1024 sc0 sc1
  s_mov_b64 exec, 0xffffff
  global_atomic_or_x2 v[118:119], v104, v[30:31], s[28:29] offset:1536 sc0 sc1
  s_mov_b64 exec, -1
  s_waitcnt vmcnt(0)
  s_nop 1
  s_branch Lrf_chk
Lapath:
  v_bfe_u32 v5, v0, 2, 2
  v_and_b32 v6, 3, v0
  v_mul_u32_u24 v20, 1040, v2
  v_lshl_add_u32 v20, v5, 8, v20
  v_and_b32 v21, 2, v0
  v_lshl_add_u32 v20, v21, 4, v20
  v_and_b32 v21, 1, v0
  v_lshl_add_u32 v25, v21, 3, v20
  v_xor_b32 v22, s30, v5
  v_lshl_add_u32 v8, v22, 6, v25
  v_add_u32 v9, 101376, v8
  s_lshl_b32 s54, s32, 13
  s_add_u32 s54, s54, 266240
  s_lshl2_add_u32 s58, s33, s30
  s_lshl_b32 s55, s58, 7
  s_add_u32 s55, s54, s55
  v_lshl_add_u32 v20, v2, 1, v3
  v_lshl_add_u32 v10, v20, 4, s55
  s_mov_b32 s50, 0x00020002
  s_mov_b32 s51, s50
  s_mov_b32 s52, 0x00030003
  s_mov_b32 s53, s52
  s_lshr_b32 s59, s33, 1
  s_mov_b32 s66, 0
  s_mov_b32 s38, 0
  s_lshl2_add_u32 s54, s32, s59
  s_lshl2_add_u32 s54, s54, s30
  s_lshl_b32 s54, s54, 7
  s_add_u32 s54, s54, 655360
  v_lshl_add_u32 v96, v1, 4, s54
  v_mov_b64 v[108:109], -1
  v_mov_b64 v[110:111], -1
  s_mov_b64 exec, 0xff
  global_store_dwordx4 v96, v[108:111], s[28:29] sc1
  s_mov_b64 exec, -1
  s_lshl3_add_u32 s37, s34, s33
  s_and_b32 s58, s36, 2
  s_lshl_b32 s54, s58, 5
  s_add_u32 s54, s54, s30
  s_lshl_b32 s54, s54, 6
  s_add_u32 s54, s54, s37
  s_lshl_b32 s54, s54, 8
  s_add_u32 s54, s54, 1048576
  v_lshlrev_b32 v20, 4, v3
  v_lshl_add_u32 v20, v2, 18, v20
  v_add_u32 v92, s54, v20
  v_lshl_add_u32 v20, v2, 4, s30
  v_lshlrev_b32 v20, 8, v20
  v_xor_b32 v92, v20, v92
  v_xor_b32 v93, 66560, v92
  v_xor_b32 v94, 133120, v92
  v_xor_b32 v95, 199680, v92
  v_lshl_add_u32 v80, v2, 10, v4
  s_lshl_b32 s54, s30, 8
  v_add_u32 v80, s54, v80
  v_add_u32 v81, 3056, v80
  v_add_u32 v82, 6112, v80
  v_add_u32 v83, 9168, v80
  s_lshl2_add_u32 s64, s37, s58
  s_lshl_b32 s64, s64, 15
  s_add_u32 s42, s6, s64
  s_addc_u32 s43, s7, 0
  s_xor_b32 s64, s64, 0x4000
  s_add_u32 s44, s6, s64
  s_addc_u32 s45, s7, 0
  s_xor_b32 s64, s64, 0xc000
  s_add_u32 s46, s6, s64
  s_addc_u32 s47, s7, 0
  s_xor_b32 s64, s64, 0x4000
  s_add_u32 s48, s6, s64
  s_addc_u32 s49, s7, 0
  v_mul_u32_u24 v20, 1040, v5
  v_lshl_add_u32 v20, v6, 8, v20
  v_xor_b32 v22, v2, v6
  v_lshl_add_u32 v20, v22, 6, v20
  v_add_u32 v97, s41, v20
  v_lshlrev_b32 v23, 4, v22
  v_lshl_add_u32 v23, v5, 6, v23
  v_lshl_add_u32 v20, v3, 8, v23
  v_add_u32 v102, 33792, v20
  s_mul_i32 s54, s30, 1088
  s_add_u32 s54, s54, 33792
  v_lshl_add_u32 v20, v2, 8, v23
  v_add_u32 v101, s54, v20
  v_lshl_add_u32 v20, v3, 9, v23
  v_add_u32 v99, s41, v20
  s_mul_i32 s54, s30, 2112
  v_lshl_add_u32 v20, v2, 9, v23
  v_add_u32 v100, s54, v20
  v_add_u32 v25, s41, v25
  v_lshl_add_u32 v88, v5, 6, v25
  v_xor_b32 v22, 1, v5
  v_lshl_add_u32 v89, v22, 6, v25
  v_xor_b32 v22, 2, v5
  v_lshl_add_u32 v90, v22, 6, v25
  v_xor_b32 v22, 3, v5
  v_lshl_add_u32 v91, v22, 6, v25
  s_lshl1_add_u32 s55, s58, s30
  s_lshl_b32 s54, s55, 13
  s_add_u32 s54, s54, 69632
  v_lshl_add_u32 v98, v1, 4, s54
  s_lshl_b32 s54, s55, 14
  s_lshl4_add_u32 s54, s37, s54
  s_add_u32 s54, s54, 524288
  v_lshl_add_u32 v20, v2, 2, v3
  v_lshl_add_u32 v103, v20, 10, s54
  v_lshl_add_u32 v20, s30, 4, v20
  v_lshlrev_b32 v20, 4, v20
  v_xor_b32 v103, v20, v103
  s_mov_b32 s56, 0x000f000f
  s_mov_b32 s57, s56
  s_lshr_b32 s54, s35, 1
  s_lshl4_add_u32 s67, s34, s54
  s_lshl_b32 s54, s67, 11
  s_add_u32 s54, s54, 786432
  v_lshl_add_u32 v104, v1, 3, s54
  s_and_b32 s54, s67, 3
  s_and_b32 s55, s67, 0xfc
  s_lshl1_add_u32 s54, s55, s54
  s_lshl_b32 s54, s54, 2
  v_and_or_b32 v20, v0, 2, s54
  v_lshl_add_u32 v105, v21, 4, v20
  v_mov_b64 v[30:31], 0
  v_lshlrev_b32 v200, 4, v1
  s_lshl3_add_u32 s39, s36, s34
  s_lshl_b32 s40, s39, 6
  s_min_u32 s40, s40, 1312
  s_cmp_lt_u32 s39, 22
  s_cselect_b64 s[60:61], -1, 1
  s_cmp_eq_u32 s39, 21
  s_cselect_b32 s62, 0xffff, 0
  s_mov_b32 s63, s62
  s_lshr_b32 s54, s30, 1
  s_and_b32 s55, s30, 1
  s_lshl3_add_u32 s54, s54, s55
  s_lshl2_add_u32 s54, s54, s40
  s_lshl2_add_u32 s54, s54, s59
  s_lshl_b32 s54, s54, 8
  v_lshl_add_u32 v20, v2, 10, v4
  v_add_u32 v201, s54, v20
  s_lshl_b32 s54, s39, 12
  s_add_u32 s54, s54, 133120
  v_add_u32 v202, s54, v200
  s_lshl2_add_u32 s58, s59, s30
  s_lshl_b32 s54, s30, 7
  s_add_u32 s54, s54, 139072
  v_lshl_add_u32 v204, v2, 4, s54
  v_and_b32 v20, 31, v0
  v_lshrrev_b32 v23, 5, v1
  v_lshl_add_u32 v20, v20, 1, v23
  v_lshl_add_u32 v203, v20, 1, s54
  s_lshl_b32 s54, s58, 9
  s_add_u32 s54, s54, s39
  s_lshl_b32 s54, s54, 5
  s_add_u32 s54, s54, 787456
  v_and_b32 v20, 14, v0
  v_lshl_add_u32 v20, v20, 10, s54
  v_lshl_add_u32 v205, v21, 4, v20
  s_waitcnt lgkmcnt(0)
  s_add_u32 s31, s31, 0x9e3779b1
  v_mov_b32 v33, s31
  v_mov_b32 v53, s31
  v_mov_b32 v55, s31
  s_waitcnt vmcnt(0)
  s_barrier
  ds_read_b64_tr_b16 v[64:65], v9 offset:4160
  ds_read_b64_tr_b16 v[66:67], v9 offset:12608
  ds_read_b64_tr_b16 v[68:69], v9 offset:21056
  ds_read_b64_tr_b16 v[70:71], v9 offset:29504
  ds_read_b64_tr_b16 v[72:73], v9 offset:4176
  ds_read_b64_tr_b16 v[74:75], v9 offset:12624
  ds_read_b64_tr_b16 v[76:77], v9 offset:21072
  ds_read_b64_tr_b16 v[78:79], v9 offset:29520
  s_waitcnt lgkmcnt(6)
  v_mfma_f32_16x16x32_bf16 v[56:59], v[64:67], v[36:39], 0
  s_waitcnt lgkmcnt(4)
  v_mfma_f32_16x16x32_bf16 v[56:59], v[68:71], v[40:43], v[56:59]
  s_waitcnt lgkmcnt(2)
  v_mfma_f32_16x16x32_bf16 v[60:63], v[72:75], v[36:39], 0
  s_waitcnt lgkmcnt(0)
  v_mfma_f32_16x16x32_bf16 v[60:63], v[76:79], v[40:43], v[60:63]
  s_nop 0
  v_cvt_pk_bf16_f32 v12, v56, v57
  v_cvt_pk_bf16_f32 v13, v58, v59
  s_nop 4
  v_cvt_pk_bf16_f32 v14, v60, v61
  v_cvt_pk_bf16_f32 v15, v62, v63
  s_mov_b64 exec, s[52:53]
  v_cndmask_b32 v52, v12, v14, s[50:51]
  v_cndmask_b32 v54, v13, v15, s[50:51]
  global_store_dwordx4 v10, v[52:55], s[28:29]
  global_store_dwordx4 v10, v[52:55], s[28:29] offset:-4096 sc1
  s_mov_b64 exec, -1
  s_barrier
  s_add_u32 m0, s41, 0
  s_nop 0
  global_load_lds_dwordx4 v80, s[42:43] offset:0
  global_load_lds_dwordx4 v81, s[42:43] offset:1040
  global_load_lds_dwordx4 v82, s[42:43] offset:2080
  global_load_lds_dwordx4 v83, s[42:43] offset:3120
  s_add_u32 m0, s41, 4160
  s_nop 0
  global_load_lds_dwordx4 v80, s[44:45] offset:0
  global_load_lds_dwordx4 v81, s[44:45] offset:1040
  global_load_lds_dwordx4 v82, s[44:45] offset:2080
  global_load_lds_dwordx4 v83, s[44:45] offset:3120
  s_add_u32 m0, s41, 33792
  s_nop 0
  global_load_lds_dwordx4 v80, s[46:47] offset:0
  global_load_lds_dwordx4 v81, s[46:47] offset:1040
  global_load_lds_dwordx4 v82, s[46:47] offset:2080
  global_load_lds_dwordx4 v83, s[46:47] offset:3120
  s_add_u32 m0, s41, 37952
  s_nop 0
  global_load_lds_dwordx4 v80, s[48:49] offset:0
  global_load_lds_dwordx4 v81, s[48:49] offset:1040
  global_load_lds_dwordx4 v82, s[48:49] offset:2080
  global_load_lds_dwordx4 v83, s[48:49] offset:3120
  global_store_dwordx4 v92, v[108:111], s[28:29] sc1
  global_store_dwordx4 v93, v[108:111], s[28:29] sc1
  global_store_dwordx4 v94, v[108:111], s[28:29] sc1
  global_store_dwordx4 v95, v[108:111], s[28:29] sc1
  s_add_u32 m0, s41, 67584
  s_xor_b32 s64, s64, 0x1c000
  s_add_u32 s42, s6, s64
  s_addc_u32 s43, s7, 0
  global_load_lds_dwordx4 v80, s[42:43] offset:0
  s_waitcnt vmcnt(13)
  global_load_lds_dwordx4 v81, s[42:43] offset:1040
  ds_read_b128 a[128:131], v97 offset:0
  ds_read_b128 a[132:135], v97 offset:16
  ds_read_b128 a[136:139], v97 offset:32
  ds_read_b128 a[140:143], v97 offset:48
  global_load_lds_dwordx4 v82, s[42:43] offset:2080
  ds_read_b128 a[144:147], v97 offset:4160
  ds_read_b128 a[148:151], v97 offset:4176
  ds_read_b128 a[152:155], v97 offset:4192
  ds_read_b128 a[156:159], v97 offset:4208
  global_load_lds_dwordx4 v83, s[42:43] offset:3120
  ds_read_b64_tr_b16 a[0:1], v88 offset:0
  ds_read_b64_tr_b16 a[2:3], v88 offset:4160
  ds_read_b64_tr_b16 a[16:17], v88 offset:16
  ds_read_b64_tr_b16 a[18:19], v88 offset:4176
  s_add_u32 m0, s41, 71744
  s_xor_b32 s64, s64, 0x4000
  s_add_u32 s44, s6, s64
  s_addc_u32 s45, s7, 0
  global_load_lds_dwordx4 v80, s[44:45] offset:0
  ds_read_b64_tr_b16 a[32:33], v89 offset:0
  ds_read_b64_tr_b16 a[34:35], v89 offset:4160
  ds_read_b64_tr_b16 a[48:49], v89 offset:16
  ds_read_b64_tr_b16 a[50:51], v89 offset:4176
  global_load_lds_dwordx4 v81, s[44:45] offset:1040
  ds_read_b64_tr_b16 a[64:65], v90 offset:0
  ds_read_b64_tr_b16 a[66:67], v90 offset:4160
  ds_read_b64_tr_b16 a[80:81], v90 offset:16
  ds_read_b64_tr_b16 a[82:83], v90 offset:4176
  global_load_lds_dwordx4 v82, s[44:45] offset:2080
  ds_read_b64_tr_b16 a[96:97], v91 offset:0
  ds_read_b64_tr_b16 a[98:99], v91 offset:4160
  ds_read_b64_tr_b16 a[112:113], v91 offset:16
  ds_read_b64_tr_b16 a[114:115], v91 offset:4176
  s_waitcnt vmcnt(11)
  global_load_lds_dwordx4 v83, s[44:45] offset:3120
  ds_read_b128 a[160:163], v97 offset:33792
  ds_read_b128 a[164:167], v97 offset:33808
  ds_read_b128 a[168:171], v97 offset:33824
  ds_read_b128 a[172:175], v97 offset:33840
  s_add_u32 m0, s41, 101376
  s_xor_b32 s64, s64, 0xc000
  s_add_u32 s46, s6, s64
  s_addc_u32 s47, s7, 0
  global_load_lds_dwordx4 v80, s[46:47] offset:0
  ds_read_b128 a[176:179], v97 offset:37952
  ds_read_b128 a[180:183], v97 offset:37968
  ds_read_b128 a[184:187], v97 offset:37984
  ds_read_b128 a[188:191], v97 offset:38000
  global_load_lds_dwordx4 v81, s[46:47] offset:1040
  ds_read_b64_tr_b16 a[4:5], v88 offset:33792
  ds_read_b64_tr_b16 a[6:7], v88 offset:37952
  ds_read_b64_tr_b16 a[20:21], v88 offset:33808
  ds_read_b64_tr_b16 a[22:23], v88 offset:37968
  global_load_lds_dwordx4 v82, s[46:47] offset:2080
  ds_read_b64_tr_b16 a[36:37], v89 offset:33792
  ds_read_b64_tr_b16 a[38:39], v89 offset:37952
  ds_read_b64_tr_b16 a[52:53], v89 offset:33808
  ds_read_b64_tr_b16 a[54:55], v89 offset:37968
  global_load_lds_dwordx4 v83, s[46:47] offset:3120
  ds_read_b64_tr_b16 a[68:69], v90 offset:33792
  ds_read_b64_tr_b16 a[70:71], v90 offset:37952
  ds_read_b64_tr_b16 a[84:85], v90 offset:33808
  ds_read_b64_tr_b16 a[86:87], v90 offset:37968
  s_add_u32 m0, s41, 105536
  s_xor_b32 s64, s64, 0x4000
  s_add_u32 s48, s6, s64
  s_addc_u32 s49, s7, 0
  global_load_lds_dwordx4 v80, s[48:49] offset:0
  ds_read_b64_tr_b16 a[100:101], v91 offset:33792
  ds_read_b64_tr_b16 a[102:103], v91 offset:37952
  ds_read_b64_tr_b16 a[116:117], v91 offset:33808
  ds_read_b64_tr_b16 a[118:119], v91 offset:37968
  global_load_lds_dwordx4 v81, s[48:49] offset:1040
  global_load_lds_dwordx4 v82, s[48:49] offset:2080
  global_load_lds_dwordx4 v83, s[48:49] offset:3120
  global_load_dwordx4 v[112:115], v98, s[28:29] offset:-4096 sc1
  v_add_u32 v97, 67584, v97
  v_add_u32 v88, 67584, v88
  v_add_u32 v89, 67584, v89
  v_add_u32 v90, 67584, v90
  v_add_u32 v91, 67584, v91
  s_waitcnt vmcnt(9)
  global_load_dwordx4 v[116:119], v98, s[28:29] offset:-3072 sc1
  ds_read_b128 a[192:195], v97 offset:0
  ds_read_b128 a[196:199], v97 offset:16
  ds_read_b128 a[200:203], v97 offset:32
  ds_read_b128 a[204:207], v97 offset:48
  global_load_dwordx4 v[120:123], v98, s[28:29] offset:-2048 sc1
  ds_read_b128 a[208:211], v97 offset:4160
  ds_read_b128 a[212:215], v97 offset:4176
  ds_read_b128 a[216:219], v97 offset:4192
  ds_read_b128 a[220:223], v97 offset:4208
  global_load_dwordx4 v[124:127], v98, s[28:29] offset:-1024 sc1
  ds_read_b64_tr_b16 a[8:9], v88 offset:0
  ds_read_b64_tr_b16 a[10:11], v88 offset:4160
  ds_read_b64_tr_b16 a[24:25], v88 offset:16
  ds_read_b64_tr_b16 a[26:27], v88 offset:4176
  global_load_dwordx4 v[128:131], v98, s[28:29] offset:0 sc1
  ds_read_b64_tr_b16 a[40:41], v89 offset:0
  ds_read_b64_tr_b16 a[42:43], v89 offset:4160
  ds_read_b64_tr_b16 a[56:57], v89 offset:16
  ds_read_b64_tr_b16 a[58:59], v89 offset:4176
  global_load_dwordx4 v[132:135], v98, s[28:29] offset:1024 sc1
  ds_read_b64_tr_b16 a[72:73], v90 offset:0
  ds_read_b64_tr_b16 a[74:75], v90 offset:4160
  ds_read_b64_tr_b16 a[88:89], v90 offset:16
  ds_read_b64_tr_b16 a[90:91], v90 offset:4176
  global_load_dwordx4 v[136:139], v98, s[28:29] offset:2048 sc1
  ds_read_b64_tr_b16 a[104:105], v91 offset:0
  ds_read_b64_tr_b16 a[106:107], v91 offset:4160
  ds_read_b64_tr_b16 a[120:121], v91 offset:16
  ds_read_b64_tr_b16 a[122:123], v91 offset:4176
  global_load_dwordx4 v[140:143], v98, s[28:29] offset:3072 sc1
  s_waitcnt vmcnt(8)
  ds_read_b128 a[224:227], v97 offset:33792
  ds_read_b128 a[228:231], v97 offset:33808
  ds_read_b128 a[232:235], v97 offset:33824
  ds_read_b128 a[236:239], v97 offset:33840
  ds_read_b128 a[240:243], v97 offset:37952
  ds_read_b128 a[244:247], v97 offset:37968
  ds_read_b128 a[248:251], v97 offset:37984
  ds_read_b128 a[252:255], v97 offset:38000
  ds_read_b64_tr_b16 a[12:13], v88 offset:33792
  ds_read_b64_tr_b16 a[14:15], v88 offset:37952
  ds_read_b64_tr_b16 a[28:29], v88 offset:33808
  ds_read_b64_tr_b16 a[30:31], v88 offset:37968
  ds_read_b64_tr_b16 a[44:45], v89 offset:33792
  ds_read_b64_tr_b16 a[46:47], v89 offset:37952
  ds_read_b64_tr_b16 a[60:61], v89 offset:33808
  ds_read_b64_tr_b16 a[62:63], v89 offset:37968
  ds_read_b64_tr_b16 a[76:77], v90 offset:33792
  ds_read_b64_tr_b16 a[78:79], v90 offset:37952
  ds_read_b64_tr_b16 a[92:93], v90 offset:33808
  ds_read_b64_tr_b16 a[94:95], v90 offset:37968
  ds_read_b64_tr_b16 a[108:109], v91 offset:33792
  ds_read_b64_tr_b16 a[110:111], v91 offset:37952
  ds_read_b64_tr_b16 a[124:125], v91 offset:33808
  ds_read_b64_tr_b16 a[126:127], v91 offset:37968
  s_add_u32 m0, s41, 0
  s_waitcnt vmcnt(6)
Lqa_chk:
  v_bitop3_b32 v12, v113, v115, s31 bitop3:0x7e
  v_mov_b32 v113, v116
  v_mov_b32 v115, v118
  v_bitop3_b32 v13, v117, v119, s31 bitop3:0x7e
  s_waitcnt lgkmcnt(15)
  v_mfma_f32_16x16x32_bf16 v[144:147], a[128:131], v[112:115], 0
  v_mfma_f32_16x16x32_bf16 v[148:151], a[144:147], v[112:115], 0
  v_mfma_f32_16x16x32_bf16 v[152:155], a[160:163], v[112:115], 0
  v_mfma_f32_16x16x32_bf16 v[156:159], a[176:179], v[112:115], 0
  v_mfma_f32_16x16x32_bf16 v[160:163], a[192:195], v[112:115], 0
  v_mfma_f32_16x16x32_bf16 v[164:167], a[208:211], v[112:115], 0
  s_waitcnt vmcnt(4)
  v_bitop3_b32 v14, v121, v123, s31 bitop3:0x7e
  v_mov_b32 v121, v124
  v_mov_b32 v123, v126
  v_bitop3_b32 v15, v125, v127, s31 bitop3:0x7e
  v_mfma_f32_16x16x32_bf16 v[168:171], a[224:227], v[112:115], 0
  v_mfma_f32_16x16x32_bf16 v[172:175], a[240:243], v[112:115], 0
  v_mfma_f32_16x16x32_bf16 v[144:147], a[132:135], v[120:123], v[144:147]
  v_mfma_f32_16x16x32_bf16 v[148:151], a[148:151], v[120:123], v[148:151]
  v_mfma_f32_16x16x32_bf16 v[152:155], a[164:167], v[120:123], v[152:155]
  v_mfma_f32_16x16x32_bf16 v[156:159], a[180:183], v[120:123], v[156:159]
  v_mfma_f32_16x16x32_bf16 v[160:163], a[196:199], v[120:123], v[160:163]
  v_mfma_f32_16x16x32_bf16 v[164:167], a[212:215], v[120:123], v[164:167]
  s_waitcnt vmcnt(2)
  v_bitop3_b32 v16, v129, v131, s31 bitop3:0x7e
  v_mov_b32 v129, v132
  v_mov_b32 v131, v134
  v_bitop3_b32 v17, v133, v135, s31 bitop3:0x7e
  v_mfma_f32_16x16x32_bf16 v[168:171], a[228:231], v[120:123], v[168:171]
  v_mfma_f32_16x16x32_bf16 v[172:175], a[244:247], v[120:123], v[172:175]
  v_mfma_f32_16x16x32_bf16 v[144:147], a[136:139], v[128:131], v[144:147]
  v_mfma_f32_16x16x32_bf16 v[148:151], a[152:155], v[128:131], v[148:151]
  s_waitcnt vmcnt(0)
  v_bitop3_b32 v18, v137, v139, s31 bitop3:0x7e
  v_mov_b32 v137, v140
  v_mov_b32 v139, v142
  v_bitop3_b32 v19, v141, v143, s31 bitop3:0x7e
  v_mfma_f32_16x16x32_bf16 v[152:155], a[168:171], v[128:131], v[152:155]
  v_mfma_f32_16x16x32_bf16 v[156:159], a[184:187], v[128:131], v[156:159]
  v_mfma_f32_16x16x32_bf16 v[160:163], a[200:203], v[128:131], v[160:163]
  v_mfma_f32_16x16x32_bf16 v[164:167], a[216:219], v[128:131], v[164:167]
  v_mfma_f32_16x16x32_bf16 v[168:171], a[232:235], v[128:131], v[168:171]
  v_mfma_f32_16x16x32_bf16 v[172:175], a[248:251], v[128:131], v[172:175]
  v_or3_b32 v12, v12, v13, v14
  v_or3_b32 v15, v15, v16, v17
  v_or3_b32 v12, v12, v18, v19
  v_or_b32 v12, v12, v15
  v_cmp_ne_u32 vcc, 0, v12
  s_cbranch_vccnz Lqa_retry
Lqa_ok:
  v_mfma_f32_16x16x32_bf16 v[144:147], a[140:143], v[136:139], v[144:147]
  v_mfma_f32_16x16x32_bf16 v[148:151], a[156:159], v[136:139], v[148:151]
  v_mfma_f32_16x16x32_bf16 v[152:155], a[172:175], v[136:139], v[152:155]
  v_mfma_f32_16x16x32_bf16 v[156:159], a[188:191], v[136:139], v[156:159]
  ds_write_b128 v99, v[144:147] offset:0
  v_mfma_f32_16x16x32_bf16 v[160:163], a[204:207], v[136:139], v[160:163]
  ds_write_b128 v99, v[148:151] offset:256
  v_mfma_f32_16x16x32_bf16 v[164:167], a[220:223], v[136:139], v[164:167]
  ds_write_b128 v99, v[152:155] offset:64
  v_mfma_f32_16x16x32_bf16 v[168:171], a[236:239], v[136:139], v[168:171]
  ds_write_b128 v99, v[156:159] offset:320
  v_mfma_f32_16x16x32_bf16 v[172:175], a[252:255], v[136:139], v[172:175]
  ds_write_b128 v99, v[160:163] offset:128
  ds_write_b128 v99, v[164:167] offset:384
  s_nop 2
  ds_write_b128 v99, v[168:171] offset:192
  s_nop 1
  ds_write_b128 v99, v[172:175] offset:448
  s_waitcnt lgkmcnt(0)
  s_barrier
  ds_read_b128 v[112:115], v100 offset:0
  ds_read_b128 v[116:119], v100 offset:256
  ds_read_b128 v[120:123], v100 offset:8448
  ds_read_b128 v[124:127], v100 offset:8704
  ds_read_b128 v[128:131], v100 offset:16896
  ds_read_b128 v[132:135], v100 offset:17152
  ds_read_b128 v[136:139], v100 offset:25344
  ds_read_b128 v[140:143], v100 offset:25600
  s_waitcnt lgkmcnt(5)
  v_pk_add_f32 v[112:113], v[112:113], v[120:121]
  v_pk_add_f32 v[114:115], v[114:115], v[122:123]
  s_waitcnt lgkmcnt(4)
  v_pk_add_f32 v[116:117], v[116:117], v[124:125]
  v_pk_add_f32 v[118:119], v[118:119], v[126:127]
  s_waitcnt lgkmcnt(3)
  v_pk_add_f32 v[112:113], v[112:113], v[128:129]
  v_pk_add_f32 v[114:115], v[114:115], v[130:131]
  s_waitcnt lgkmcnt(2)
  v_pk_add_f32 v[116:117], v[116:117], v[132:133]
  v_pk_add_f32 v[118:119], v[118:119], v[134:135]
  s_waitcnt lgkmcnt(1)
  v_pk_add_f32 v[112:113], v[112:113], v[136:137]
  v_pk_add_f32 v[114:115], v[114:115], v[138:139]
  s_waitcnt lgkmcnt(0)
  v_pk_add_f32 v[116:117], v[116:117], v[140:141]
  v_pk_add_f32 v[118:119], v[118:119], v[142:143]
  v_max3_f32 v12, v112, v113, v114
  v_max3_f32 v12, v12, v115, v116
  v_max3_f32 v13, v117, v118, v119
  v_max_f32 v52, v12, v13
  s_nop 1
  v_max_f32_dpp v52, v52, v52 quad_perm:[1,0,3,2] row_mask:0xf bank_mask:0xf
  s_nop 1
  v_max_f32_dpp v52, v52, v52 quad_perm:[2,3,0,1] row_mask:0xf bank_mask:0xf
  s_nop 1
  v_max_f32_dpp v52, v52, v52 row_half_mirror row_mask:0xf bank_mask:0xf
  s_nop 1
  v_max_f32_dpp v52, v52, v52 row_mirror row_mask:0xf bank_mask:0xf
  v_pk_add_f32 v[112:113], v[112:113], v[52:53] op_sel_hi:[1,0] neg_lo:[0,1] neg_hi:[0,1]
  v_pk_add_f32 v[114:115], v[114:115], v[52:53] op_sel_hi:[1,0] neg_lo:[0,1] neg_hi:[0,1]
  v_pk_add_f32 v[116:117], v[116:117], v[52:53] op_sel_hi:[1,0] neg_lo:[0,1] neg_hi:[0,1]
  v_pk_add_f32 v[118:119], v[118:119], v[52:53] op_sel_hi:[1,0] neg_lo:[0,1] neg_hi:[0,1]
  v_exp_f32 v112, v112
  v_exp_f32 v113, v113
  v_exp_f32 v114, v114
  v_cvt_pk_bf16_f32 v56, v112, v113
  v_exp_f32 v115, v115
  v_exp_f32 v116, v116
  v_cvt_pk_bf16_f32 v57, v114, v115
  v_exp_f32 v117, v117
  v_exp_f32 v118, v118
  v_cvt_pk_bf16_f32 v58, v116, v117
  v_exp_f32 v119, v119
  s_nop 0
  v_cvt_pk_bf16_f32 v59, v118, v119
  ds_write_b128 v101, v[56:59]
  v_pk_add_f32 v[112:113], v[112:113], v[114:115]
  v_pk_add_f32 v[116:117], v[116:117], v[118:119]
  v_pk_add_f32 v[112:113], v[112:113], v[116:117]
  v_add_f32 v54, v112, v113
  s_waitcnt lgkmcnt(0)
  s_barrier
  ds_read_b128 v[64:67], v102 offset:0
  ds_read_b128 v[68:71], v102 offset:64
  ds_read_b128 v[72:75], v102 offset:128
  ds_read_b128 v[76:79], v102 offset:192
  v_add_f32_dpp v54, v54, v54 quad_perm:[1,0,3,2] row_mask:0xf bank_mask:0xf
  s_nop 1
  v_add_f32_dpp v54, v54, v54 quad_perm:[2,3,0,1] row_mask:0xf bank_mask:0xf
  s_nop 1
  v_add_f32_dpp v54, v54, v54 row_half_mirror row_mask:0xf bank_mask:0xf
  s_nop 1
  v_add_f32_dpp v54, v54, v54 row_mirror row_mask:0xf bank_mask:0xf
  s_mov_b64 exec, s[56:57]
  global_store_dwordx4 v103, v[52:55], s[28:29] sc1
  s_mov_b64 exec, -1
  s_waitcnt lgkmcnt(3)
  v_mfma_f32_16x16x32_bf16 v[144:147], v[64:67], a[0:3], 0
  v_mfma_f32_16x16x32_bf16 v[148:151], v[64:67], a[16:19], 0
  s_waitcnt lgkmcnt(2)
  v_mfma_f32_16x16x32_bf16 v[144:147], v[68:71], a[4:7], v[144:147]
  v_mfma_f32_16x16x32_bf16 v[148:151], v[68:71], a[20:23], v[148:151]
  s_waitcnt lgkmcnt(1)
  v_mfma_f32_16x16x32_bf16 v[144:147], v[72:75], a[8:11], v[144:147]
  v_mfma_f32_16x16x32_bf16 v[148:151], v[72:75], a[24:27], v[148:151]
  s_waitcnt lgkmcnt(0)
  v_mfma_f32_16x16x32_bf16 v[144:147], v[76:79], a[12:15], v[144:147]
  v_mfma_f32_16x16x32_bf16 v[148:151], v[76:79], a[28:31], v[148:151]
  v_mfma_f32_16x16x32_bf16 v[152:155], v[64:67], a[32:35], 0
  v_mfma_f32_16x16x32_bf16 v[156:159], v[64:67], a[48:51], 0
  v_mfma_f32_16x16x32_bf16 v[152:155], v[68:71], a[36:39], v[152:155]
  v_cvt_pk_bf16_f32 v176, v144, v148
  v_cvt_pk_bf16_f32 v180, v145, v149
  v_mfma_f32_16x16x32_bf16 v[156:159], v[68:71], a[52:55], v[156:159]
  v_cvt_pk_bf16_f32 v184, v146, v150
  v_cvt_pk_bf16_f32 v188, v147, v151
  v_mfma_f32_16x16x32_bf16 v[152:155], v[72:75], a[40:43], v[152:155]
  v_mfma_f32_16x16x32_bf16 v[156:159], v[72:75], a[56:59], v[156:159]
  v_mfma_f32_16x16x32_bf16 v[152:155], v[76:79], a[44:47], v[152:155]
  v_mfma_f32_16x16x32_bf16 v[156:159], v[76:79], a[60:63], v[156:159]
  v_mfma_f32_16x16x32_bf16 v[160:163], v[64:67], a[64:67], 0
  v_mfma_f32_16x16x32_bf16 v[164:167], v[64:67], a[80:83], 0
  v_mfma_f32_16x16x32_bf16 v[160:163], v[68:71], a[68:71], v[160:163]
  v_cvt_pk_bf16_f32 v177, v152, v156
  v_cvt_pk_bf16_f32 v181, v153, v157
  v_mfma_f32_16x16x32_bf16 v[164:167], v[68:71], a[84:87], v[164:167]
  v_cvt_pk_bf16_f32 v185, v154, v158
  v_cvt_pk_bf16_f32 v189, v155, v159
  v_mfma_f32_16x16x32_bf16 v[160:163], v[72:75], a[72:75], v[160:163]
  v_mfma_f32_16x16x32_bf16 v[164:167], v[72:75], a[88:91], v[164:167]
  v_mfma_f32_16x16x32_bf16 v[160:163], v[76:79], a[76:79], v[160:163]
  v_mfma_f32_16x16x32_bf16 v[164:167], v[76:79], a[92:95], v[164:167]
  v_mfma_f32_16x16x32_bf16 v[168:171], v[64:67], a[96:99], 0
  v_mfma_f32_16x16x32_bf16 v[172:175], v[64:67], a[112:115], 0
  v_mfma_f32_16x16x32_bf16 v[168:171], v[68:71], a[100:103], v[168:171]
  v_cvt_pk_bf16_f32 v178, v160, v164
  v_cvt_pk_bf16_f32 v182, v161, v165
  v_mfma_f32_16x16x32_bf16 v[172:175], v[68:71], a[116:119], v[172:175]
  v_cvt_pk_bf16_f32 v186, v162, v166
  v_cvt_pk_bf16_f32 v190, v163, v167
  v_mfma_f32_16x16x32_bf16 v[168:171], v[72:75], a[104:107], v[168:171]
  v_mfma_f32_16x16x32_bf16 v[172:175], v[72:75], a[120:123], v[172:175]
  v_mfma_f32_16x16x32_bf16 v[168:171], v[76:79], a[108:111], v[168:171]
  v_mfma_f32_16x16x32_bf16 v[172:175], v[76:79], a[124:127], v[172:175]
  s_nop 7
  v_cvt_pk_bf16_f32 v179, v168, v172
  global_store_dwordx4 v92, v[176:179], s[28:29] sc1
  v_cvt_pk_bf16_f32 v183, v169, v173
  global_store_dwordx4 v93, v[180:183], s[28:29] sc1
  v_cvt_pk_bf16_f32 v187, v170, v174
  global_store_dwordx4 v94, v[184:187], s[28:29] sc1
  v_cvt_pk_bf16_f32 v191, v171, v175
  global_store_dwordx4 v95, v[188:191], s[28:29] sc1
  s_barrier
  s_cmp_lt_u32 s30, 1
  s_cselect_b64 exec, -1, 1
  global_load_dwordx4 v[192:195], v200, s[4:5]
  global_load_dwordx4 v[196:199], v200, s[22:23]
  s_mov_b64 exec, -1
  s_cmp_ge_u32 s39, 22
  s_cbranch_scc1 Lnf
  global_load_dwordx4 v[112:115], v202, s[28:29] offset:0 sc1
  global_load_dwordx4 v[116:119], v202, s[28:29] offset:1024 sc1
  s_add_u32 m0, s41, 101376
  s_nop 0
  global_load_lds_dwordx4 v201, s[20:21] offset:0
  v_add_u32 v201, 0x1bf0, v201
  global_load_lds_dwordx4 v201, s[20:21] offset:1040
  v_add_u32 v201, 0x1bf0, v201
  global_load_lds_dwordx4 v201, s[20:21] offset:2080
  v_add_u32 v201, 0x1bf0, v201
  global_load_lds_dwordx4 v201, s[20:21] offset:3120
  s_waitcnt vmcnt(4)
Lf_chk:
  v_bitop3_b32 v12, v113, v115, s31 bitop3:0x7e
  v_bitop3_b32 v13, v117, v119, s31 bitop3:0x7e
  v_or_b32 v12, v12, v13
  v_cmp_ne_u32 vcc, 0, v12
  s_cbranch_vccnz Lf_retry
Lf_ok:
  v_add_f32 v12, v112, v116
  v_add_f32 v13, v114, v118
  s_nop 1
  v_permlane32_swap_b32 v12, v13
  v_add_f32 v12, v12, v13
  v_mul_f32 v13, 0xbfb8aa3b, v12
  v_exp_f32 v13, v13
  v_cndmask_b32 v12, v12, v30, s[62:63]
  v_add_f32 v13, 1.0, v13
  v_rcp_f32 v13, v13
  s_nop 0
  v_mul_f32 v12, v12, v13
  v_cvt_pk_bf16_f32 v12, v12, v12
  ds_write_b16 v203, v12
  ds_read_b128 v[64:67], v204 offset:0
  ds_read_b128 v[68:71], v204 offset:64
  s_waitcnt vmcnt(0)
  s_barrier
  ds_read_b64_tr_b16 a[128:129], v9 offset:0
  ds_read_b64_tr_b16 a[136:137], v9 offset:16
  ds_read_b64_tr_b16 a[130:131], v9 offset:8448
  ds_read_b64_tr_b16 a[138:139], v9 offset:8464
  ds_read_b64_tr_b16 a[132:133], v9 offset:16896
  ds_read_b64_tr_b16 a[140:141], v9 offset:16912
  ds_read_b64_tr_b16 a[134:135], v9 offset:25344
  ds_read_b64_tr_b16 a[142:143], v9 offset:25360
  s_waitcnt lgkmcnt(4)
  v_mfma_f32_16x16x32_bf16 v[56:59], v[64:67], a[128:131], 0
  v_mfma_f32_16x16x32_bf16 v[60:63], v[64:67], a[136:139], 0
  s_waitcnt lgkmcnt(0)
  v_mfma_f32_16x16x32_bf16 v[56:59], v[68:71], a[132:135], v[56:59]
  v_mfma_f32_16x16x32_bf16 v[60:63], v[68:71], a[140:143], v[60:63]
  s_mov_b64 exec, 0xffff
  s_nop 3
  v_mov_b32 v52, v56
  s_nop 1
  v_mov_b32 v54, v60
  global_store_dwordx4 v205, v[52:55], s[28:29] sc1
  s_mov_b64 exec, -1
Lnf:
  s_cmp_ge_u32 s30, 1
  s_cbranch_scc1 Lfin
  v_mov_b32 v118, 0
  v_mov_b32 v119, s31
  v_mov_b32 v126, 0
  v_mov_b32 v127, s31
  global_atomic_or_x2 v[112:113], v104, v[30:31], s[28:29] offset:0 sc0 sc1
  global_atomic_or_x2 v[114:115], v104, v[30:31], s[28:29] offset:512 sc0 sc1
  global_atomic_or_x2 v[116:117], v104, v[30:31], s[28:29] offset:1024 sc0 sc1
  s_mov_b64 exec, 0xffffff
  global_atomic_or_x2 v[118:119], v104, v[30:31], s[28:29] offset:1536 sc0 sc1
  s_mov_b64 exec, -1
  s_waitcnt vmcnt(4)
  v_dot2_f32_bf16 v12, v192, v196, 0
  v_dot2_f32_bf16 v12, v193, v197, v12
  v_dot2_f32_bf16 v12, v194, v198, v12
  v_dot2_f32_bf16 v12, v195, v199, v12
  s_nop 2
  v_add_f32_dpp v12, v12, v12 quad_perm:[1,0,3,2] row_mask:0xf bank_mask:0xf
  s_nop 1
  v_add_f32_dpp v12, v12, v12 quad_perm:[2,3,0,1] row_mask:0xf bank_mask:0xf
  s_nop 1
  v_add_f32_dpp v12, v12, v12 row_half_mirror row_mask:0xf bank_mask:0xf
  s_nop 1
  v_add_f32_dpp v12, v12, v12 row_mirror row_mask:0xf bank_mask:0xf
  v_mov_b32 v13, v12
  s_nop 1
  v_permlane16_swap_b32 v13, v12
  v_add_f32 v12, v12, v13
  v_mov_b32 v13, v12
  s_nop 1
  v_permlane32_swap_b32 v13, v12
  v_add_f32 v12, v12, v13
  v_mul_f32 v12, 0xbfb8aa3b, v12
  v_exp_f32 v12, v12
  s_nop 0
  v_add_f32 v12, 1.0, v12
  v_rcp_f32 v206, v12
  s_nop 0
  v_sub_f32 v19, 1.0, v206
  s_waitcnt vmcnt(0)
Lrf_chk:
  v_bitop3_b32 v14, v117, v119, s31 bitop3:0x7e
  v_add_f32 v18, v116, v118
  v_cmp_ne_u32 vcc, 0, v14
  v_mul_f32 v18, v18, v19
  s_cbranch_vccnz Lrf_retry
Lrf_ok:
  global_atomic_or_x2 v[120:121], v104, v[30:31], s[28:29] offset:0 sc0 sc1
  global_atomic_or_x2 v[122:123], v104, v[30:31], s[28:29] offset:512 sc0 sc1
Lr_loop:
  s_waitcnt vmcnt(2)
  v_bitop3_b32 v13, v113, v115, s31 bitop3:0x7e
  v_add_f32 v15, v112, v114
  v_cmp_ne_u32 vcc, 0, v13
  v_fma_f32 v12, v15, v206, v18
  s_cbranch_vccz Lr_ok
  global_atomic_or_x2 v[112:113], v104, v[30:31], s[28:29] offset:0 sc0 sc1
  global_atomic_or_x2 v[114:115], v104, v[30:31], s[28:29] offset:512 sc0 sc1
  s_waitcnt vmcnt(2)
  v_bitop3_b32 v13, v121, v123, s31 bitop3:0x7e
  v_add_f32 v15, v120, v122
  v_cmp_ne_u32 vcc, 0, v13
  v_fma_f32 v12, v15, v206, v18
  s_cbranch_vccz Lr_ok
  global_atomic_or_x2 v[120:121], v104, v[30:31], s[28:29] offset:0 sc0 sc1
  global_atomic_or_x2 v[122:123], v104, v[30:31], s[28:29] offset:512 sc0 sc1
  s_add_u32 s66, s66, 1
  s_cmp_le_u32 s66, 20000
  s_cbranch_scc1 Lr_loop
Lr_ok:
  s_nop 1
  v_add_f32_dpp v12, v12, v12 row_ror:4 row_mask:0xf bank_mask:0xf
  s_nop 1
  v_add_f32_dpp v13, v12, v12 row_ror:8 row_mask:0xf bank_mask:0xf
  v_add_f32_dpp v12, v12, v12 row_ror:8 row_mask:0xf bank_mask:0xf
  s_nop 1
  v_permlane16_swap_b32 v12, v13
  v_add_f32 v14, v12, v13
  v_add_f32 v12, v12, v13
  s_nop 1
  v_permlane32_swap_b32 v12, v14
  s_mov_b64 exec, 15
  v_add_f32 v12, v12, v14
  v_cvt_pk_bf16_f32 v12, v12, v12
  global_store_short v105, v12, s[24:25]
  s_cmp_lg_u32 s67, 0
  s_cbranch_scc1 Lfin
  s_mov_b64 exec, 1
  global_store_dword v30, v33, s[28:29]
Lfin:
  s_endpgm
Lq_retry:
  s_nop 7
  s_add_u32 s66, s66, 1
  s_cmp_gt_u32 s66, 20000
  s_cbranch_scc1 Lq_ok
  s_waitcnt lgkmcnt(0)
  s_add_u32 s38, s38, 1
  s_cmp_ge_u32 s38, 12
  s_cbranch_scc1 Lq_far
  global_load_dwordx4 v[112:115], v80, s[28:29] sc1
  s_waitcnt vmcnt(0)
  s_nop 1
  s_branch Lq_chk
Lq_far:
  s_cmp_lg_u32 s38, 12
  s_cbranch_scc1 Lq_far2
  s_mov_b64 exec, s[52:53]
  global_store_dwordx4 v10, v[52:55], s[28:29] offset:-4096 sc1
  s_mov_b64 exec, -1
Lq_far2:
  global_load_dwordx4 v[112:115], v80, s[28:29] offset:-4096 sc1
  s_waitcnt vmcnt(0)
  s_nop 1
  s_branch Lq_chk
Lo_retry:
  s_nop 7
  s_add_u32 s66, s66, 1
  s_cmp_gt_u32 s66, 20000
  s_cbranch_scc1 Lo_ok
  s_waitcnt lgkmcnt(0)
  v_max3_u32 v12, v116, v117, v118
  v_max3_u32 v13, v120, v121, v122
  v_max3_u32 v14, v124, v125, v126
  v_max3_u32 v15, v128, v129, v130
  v_max_u32 v12, v12, v119
  v_max_u32 v13, v13, v123
  v_max_u32 v14, v14, v127
  v_max_u32 v15, v15, v131
  v_cmp_eq_u32 s[44:45], -1, v12
  v_cmp_eq_u32 s[46:47], -1, v13
  v_cmp_eq_u32 s[48:49], -1, v14
  v_cmp_eq_u32 s[62:63], -1, v15
  s_mov_b64 exec, s[44:45]
  global_load_dwordx4 v[116:119], v90, s[28:29] offset:0 sc1
  s_mov_b64 exec, s[46:47]
  global_load_dwordx4 v[120:123], v90, s[28:29] offset:1024 sc1
  s_mov_b64 exec, s[48:49]
  global_load_dwordx4 v[124:127], v90, s[28:29] offset:2048 sc1
  s_mov_b64 exec, s[62:63]
  global_load_dwordx4 v[128:131], v90, s[28:29] offset:3072 sc1
  s_mov_b64 exec, -1
  s_waitcnt vmcnt(0)
  s_nop 1
  s_branch Lo_chk
Ly_retry:
  s_nop 7
  s_add_u32 s66, s66, 1
  s_cmp_gt_u32 s66, 20000
  s_cbranch_scc1 Ly_ok
  s_waitcnt lgkmcnt(0)
  s_add_u32 s38, s38, 1
  s_cmp_ge_u32 s38, 12
  s_cbranch_scc1 Ly_far
  s_mov_b64 exec, s[56:57]
  global_load_dwordx4 v[132:135], v96, s[28:29] offset:0 sc1
  global_load_dwordx4 v[136:139], v96, s[28:29] offset:256 sc1
  global_load_dwordx4 v[140:143], v96, s[28:29] offset:512 sc1
  global_load_dwordx4 v[144:147], v96, s[28:29] offset:768 sc1
  s_mov_b64 exec, -1
  s_waitcnt vmcnt(0)
  s_nop 1
  s_branch Ly_chk
Ly_far:
  s_cmp_lg_u32 s38, 12
  s_cbranch_scc1 Ly_far2
  s_mov_b64 exec, 0x55555555
  global_store_dword v95, v98, s[28:29] offset:-1024 sc1
Ly_far2:
  s_mov_b64 exec, s[56:57]
  global_load_dwordx4 v[132:135], v96, s[28:29] offset:-1024 sc1
  global_load_dwordx4 v[136:139], v96, s[28:29] offset:-768 sc1
  global_load_dwordx4 v[140:143], v96, s[28:29] offset:-512 sc1
  global_load_dwordx4 v[144:147], v96, s[28:29] offset:-256 sc1
  s_mov_b64 exec, -1
  s_waitcnt vmcnt(0)
  s_nop 1
  s_branch Ly_chk
Lcode_end:
.section .rodata,"a"
.p2align 6
.amdhsa_kernel gated_mix__compressed_kv_cla__dense_activation_silu__decode_kernel
  .amdhsa_next_free_vgpr 512
  .amdhsa_next_free_sgpr 102
  .amdhsa_accum_offset 256
  .amdhsa_group_segment_fixed_size 0
  .amdhsa_kernarg_size 104
  .amdhsa_user_sgpr_count 2
  .amdhsa_user_sgpr_kernarg_segment_ptr 1
  .amdhsa_system_sgpr_workgroup_id_x 1
.end_amdhsa_kernel
```
